```python
import torch

def _softmax(x, axis=-1):
    return torch.softmax(x, dim=axis)
def _gelu(x):
    return torch.nn.functional.gelu(x, approximate="tanh")
def _silu(x):
    return torch.nn.functional.silu(x)
def _sigmoid(x):
    return torch.sigmoid(x)
def _layernorm(x, axis=-1, eps=1e-5):
    m = x.mean(dim=axis, keepdim=True)
    v = x.var(dim=axis, keepdim=True, unbiased=False)
    return (x - m) / torch.sqrt(v + eps)
def _scatter_add(tgt, idx, src, axis=0):
    return tgt.clone().index_add_(axis, idx, src)
def _segment_sum(src, seg, n):
    out = torch.zeros((n,) + src.shape[1:], dtype=src.dtype)
    return out.index_add_(0, seg, src)
def _pad(x, pw):
    flat = tuple(v for pair in reversed(pw) for v in pair)
    return torch.nn.functional.pad(x, flat)

kernel_name = 'standalone__batchnorm__prompt'

def setup_inputs():

    _w = (lambda a: (lambda t: t.to(torch.bfloat16) if t.is_floating_point() else t)(torch.as_tensor(a)))
    B, S, C = 2, 2048, 576
    K = 3
    return {
        "x": _w((lambda *s: torch.randn(*s, dtype=torch.bfloat16) * 0.05)(B, S, C)),
        "w": _w((lambda *s: torch.randn(*s, dtype=torch.bfloat16) * 0.05)(K, C, C) * (1.0 / (K * C) ** 0.5)),
        "mean": _w((lambda *s: torch.randn(*s, dtype=torch.bfloat16) * 0.05)(C) * 0.1),
        "var": _w(torch.abs((lambda *s: torch.randn(*s, dtype=torch.bfloat16) * 0.05)(C)) + 0.5),
        "g": _w((lambda *s: torch.randn(*s, dtype=torch.bfloat16) * 0.05)(C) + 1.0),
        "b": _w((lambda *s: torch.randn(*s, dtype=torch.bfloat16) * 0.05)(C) * 0.1),
    }

def reference(x, w, mean, var, g, b):
    K = 3
    P = K // 2
    S = x.shape[1]
    xp = _pad(x, ((0, 0), (P, P), (0, 0)))
    y = sum(torch.einsum('bsc,cd->bsd', xp[:, k:k + S, :], w[k]) for k in range(K))
    inv_std = 1.0 / torch.sqrt(var + 1e-5)
    y = (y - mean) * (g * inv_std) + b
    return _silu(y)
```

```asm
; @launch grid=(252,1,1) block=(384,1,1) lds=135936
.amdgcn_target "amdgcn-amd-amdhsa--gfx950"
.text
.globl standalone__batchnorm__prompt_kernel
.p2align 8
.type standalone__batchnorm__prompt_kernel,@function
standalone__batchnorm__prompt_kernel:
  s_load_dwordx16 s[4:19], s[0:1], 0
  s_cmp_ge_u32 s2, 252
  s_cbranch_scc1 L_end
  s_and_b32 s20, s2, 7
  s_lshr_b32 s21, s2, 3
  s_mul_i32 s22, s20, 31
  s_min_u32 s23, s20, 4
  s_add_u32 s22, s22, s23
  s_add_u32 s22, s22, s21
  s_mul_i32 s23, s22, 57
  s_lshr_b32 s23, s23, 9
  s_mul_i32 s24, s23, 9
  s_sub_u32 s24, s22, s24
  s_cmp_ge_u32 s23, 14
  s_cselect_b32 s25, 1, 0
  s_mul_i32 s26, s25, 14
  s_sub_u32 s26, s23, s26
  s_mul_i32 s27, s26, 147
  s_mov_b32 s28, 147
  s_cmp_eq_u32 s26, 13
  s_cselect_b32 s28, 137, s28
  v_lshrrev_b32 v1, 6, v0
  v_and_b32 v0, 63, v0
  s_nop 1
  v_readfirstlane_b32 s29, v1
  s_waitcnt lgkmcnt(0)
  s_cmp_ge_u32 s29, 4
  s_cbranch_scc1 L_loader
  s_lshl_b32 s30, s24, 7
  s_lshl_b32 s31, s29, 5
  s_add_u32 s30, s30, s31
  v_lshrrev_b32 v2, 4, v0
  v_lshlrev_b32 v4, 3, v2
  v_add_u32 v4, s30, v4
  s_mov_b32 s36, s8
  s_mov_b32 s37, s9
  s_mov_b32 s38, 1152
  s_mov_b32 s39, 0x00020000
  s_mov_b32 s40, s10
  s_mov_b32 s41, s11
  s_mov_b32 s42, 1152
  s_mov_b32 s43, 0x00020000
  s_mov_b32 s44, s12
  s_mov_b32 s45, s13
  s_mov_b32 s46, 1152
  s_mov_b32 s47, 0x00020000
  s_mov_b32 s48, s14
  s_mov_b32 s49, s15
  s_mov_b32 s50, 1152
  s_mov_b32 s51, 0x00020000
  buffer_load_dwordx2 v[208:209], v4, s[36:39], 0 offen
  buffer_load_dwordx2 v[210:211], v4, s[40:43], 0 offen
  buffer_load_dwordx2 v[212:213], v4, s[44:47], 0 offen
  buffer_load_dwordx2 v[214:215], v4, s[48:51], 0 offen
  v_and_b32 v1, 15, v0
  v_lshlrev_b32 v3, 2, v1
  v_add_u32 v3, v3, v1
  v_add_u32 v4, 0, v3
  v_and_b32 v5, 7, v4
  v_xor_b32 v5, v5, v2
  v_lshlrev_b32 v5, 4, v5
  v_lshlrev_b32 v4, 7, v4
  v_add_u32 v184, v4, v5
  v_xor_b32 v191, 64, v184
  v_add_u32 v4, 1, v3
  v_and_b32 v5, 7, v4
  v_xor_b32 v5, v5, v2
  v_lshlrev_b32 v5, 4, v5
  v_lshlrev_b32 v4, 7, v4
  v_add_u32 v185, v4, v5
  v_xor_b32 v192, 64, v185
  v_add_u32 v4, 2, v3
  v_and_b32 v5, 7, v4
  v_xor_b32 v5, v5, v2
  v_lshlrev_b32 v5, 4, v5
  v_lshlrev_b32 v4, 7, v4
  v_add_u32 v186, v4, v5
  v_xor_b32 v193, 64, v186
  v_add_u32 v4, 3, v3
  v_and_b32 v5, 7, v4
  v_xor_b32 v5, v5, v2
  v_lshlrev_b32 v5, 4, v5
  v_lshlrev_b32 v4, 7, v4
  v_add_u32 v187, v4, v5
  v_xor_b32 v194, 64, v187
  v_add_u32 v4, 4, v3
  v_and_b32 v5, 7, v4
  v_xor_b32 v5, v5, v2
  v_lshlrev_b32 v5, 4, v5
  v_lshlrev_b32 v4, 7, v4
  v_add_u32 v188, v4, v5
  v_xor_b32 v195, 64, v188
  v_add_u32 v4, 5, v3
  v_and_b32 v5, 7, v4
  v_xor_b32 v5, v5, v2
  v_lshlrev_b32 v5, 4, v5
  v_lshlrev_b32 v4, 7, v4
  v_add_u32 v189, v4, v5
  v_xor_b32 v196, 64, v189
  v_add_u32 v4, 6, v3
  v_and_b32 v5, 7, v4
  v_xor_b32 v5, v5, v2
  v_lshlrev_b32 v5, 4, v5
  v_lshlrev_b32 v4, 7, v4
  v_add_u32 v190, v4, v5
  v_xor_b32 v197, 64, v190
  v_lshrrev_b32 v4, 2, v1
  v_and_b32 v5, 3, v0
  v_lshrrev_b32 v6, 1, v4
  v_and_b32 v6, 1, v6
  v_and_b32 v7, 1, v2
  v_lshlrev_b32 v7, 1, v7
  v_or_b32 v6, v6, v7
  v_xor_b32 v6, s29, v6
  v_lshlrev_b32 v6, 5, v6
  v_lshlrev_b32 v7, 3, v2
  v_add_u32 v7, v7, v4
  v_lshlrev_b32 v7, 7, v7
  v_add_u32 v6, v6, v7
  v_lshlrev_b32 v5, 3, v5
  v_add_u32 v6, v6, v5
  v_add_u32 v198, 62208, v6
  v_add_u32 v199, 66304, v6
  v_mul_u32_u24 v4, 1152, v3
  v_lshlrev_b32 v5, 3, v2
  v_add_u32 v4, v4, v5
  s_lshl_b32 s30, s29, 5
  v_add_u32 v228, s30, v4
  s_lshl_b32 s30, s25, 11
  s_add_u32 s30, s30, s27
  s_mul_i32 s30, s30, 1152
  s_lshl_b32 s31, s24, 7
  s_add_u32 s30, s30, s31
  s_add_u32 s32, s16, s30
  s_addc_u32 s33, s17, 0
  s_mul_i32 s34, s28, 1152
  s_sub_u32 s34, s34, 1024
  s_mov_b32 s35, 0x00020000
  s_lshl_b32 s30, s29, 1
  v_lshrrev_b32 v4, 1, v2
  v_add_u32 v4, s30, v4
  v_and_b32 v5, 1, v2
  v_lshlrev_b32 v5, 3, v5
  v_add_u32 v6, 0, v3
  v_and_b32 v7, 7, v6
  v_xor_b32 v7, v7, v4
  v_lshlrev_b32 v7, 4, v7
  v_lshlrev_b32 v6, 7, v6
  v_add_u32 v6, v6, v7
  v_add_u32 v232, v6, v5
  v_add_u32 v6, 1, v3
  v_and_b32 v7, 7, v6
  v_xor_b32 v7, v7, v4
  v_lshlrev_b32 v7, 4, v7
  v_lshlrev_b32 v6, 7, v6
  v_add_u32 v6, v6, v7
  v_add_u32 v233, v6, v5
  v_add_u32 v6, 2, v3
  v_and_b32 v7, 7, v6
  v_xor_b32 v7, v7, v4
  v_lshlrev_b32 v7, 4, v7
  v_lshlrev_b32 v6, 7, v6
  v_add_u32 v6, v6, v7
  v_add_u32 v234, v6, v5
  v_add_u32 v6, 3, v3
  v_and_b32 v7, 7, v6
  v_xor_b32 v7, v7, v4
  v_lshlrev_b32 v7, 4, v7
  v_lshlrev_b32 v6, 7, v6
  v_add_u32 v6, v6, v7
  v_add_u32 v235, v6, v5
  v_add_u32 v6, 4, v3
  v_and_b32 v7, 7, v6
  v_xor_b32 v7, v7, v4
  v_lshlrev_b32 v7, 4, v7
  v_lshlrev_b32 v6, 7, v6
  v_add_u32 v6, v6, v7
  v_add_u32 v236, v6, v5
  s_lshl_b32 s30, s29, 10
  v_lshlrev_b32 v4, 4, v0
  v_add_u32 v237, s30, v4
  v_lshrrev_b32 v4, 3, v0
  v_and_b32 v5, 7, v0
  v_xor_b32 v5, v5, v4
  v_lshlrev_b32 v5, 4, v5
  s_lshl_b32 s30, s29, 3
  v_add_u32 v4, s30, v4
  v_mul_u32_u24 v4, 1152, v4
  v_add_u32 v238, v4, v5
  v_mov_b32 v8, 0
  v_mov_b32 v9, 0
  v_mov_b32 v10, 0
  v_mov_b32 v11, 0
  v_mov_b32 v12, 0
  v_mov_b32 v13, 0
  v_mov_b32 v14, 0
  v_mov_b32 v15, 0
  v_mov_b32 v16, 0
  v_mov_b32 v17, 0
  v_mov_b32 v18, 0
  v_mov_b32 v19, 0
  v_mov_b32 v20, 0
  v_mov_b32 v21, 0
  v_mov_b32 v22, 0
  v_mov_b32 v23, 0
  v_mov_b32 v24, 0
  v_mov_b32 v25, 0
  v_mov_b32 v26, 0
  v_mov_b32 v27, 0
  v_mov_b32 v28, 0
  v_mov_b32 v29, 0
  v_mov_b32 v30, 0
  v_mov_b32 v31, 0
  v_mov_b32 v32, 0
  v_mov_b32 v33, 0
  v_mov_b32 v34, 0
  v_mov_b32 v35, 0
  v_mov_b32 v36, 0
  v_mov_b32 v37, 0
  v_mov_b32 v38, 0
  v_mov_b32 v39, 0
  v_mov_b32 v40, 0
  v_mov_b32 v41, 0
  v_mov_b32 v42, 0
  v_mov_b32 v43, 0
  v_mov_b32 v44, 0
  v_mov_b32 v45, 0
  v_mov_b32 v46, 0
  v_mov_b32 v47, 0
  s_waitcnt vmcnt(0)
  v_lshlrev_b32 v216, 16, v208
  v_and_b32 v217, 0xffff0000, v208
  v_lshlrev_b32 v218, 16, v209
  v_and_b32 v219, 0xffff0000, v209
  v_lshlrev_b32 v220, 16, v210
  v_and_b32 v221, 0xffff0000, v210
  v_lshlrev_b32 v222, 16, v211
  v_and_b32 v223, 0xffff0000, v211
  v_lshlrev_b32 v224, 16, v212
  v_and_b32 v225, 0xffff0000, v212
  v_lshlrev_b32 v226, 16, v213
  v_and_b32 v227, 0xffff0000, v213
  v_lshlrev_b32 v204, 16, v214
  v_and_b32 v205, 0xffff0000, v214
  v_lshlrev_b32 v206, 16, v215
  v_and_b32 v207, 0xffff0000, v215
  v_mov_b32 v1, 0x3727c5ac
  v_add_f32 v220, v220, v1
  v_cvt_pk_bf16_f32 v220, v220, v220
  v_lshlrev_b32 v220, 16, v220
  v_sqrt_f32 v220, v220
  s_nop 0
  v_cvt_pk_bf16_f32 v220, v220, v220
  v_lshlrev_b32 v220, 16, v220
  v_rcp_f32 v220, v220
  s_nop 0
  v_cvt_pk_bf16_f32 v220, v220, v220
  v_lshlrev_b32 v220, 16, v220
  v_mul_f32 v220, v224, v220
  v_cvt_pk_bf16_f32 v220, v220, v220
  v_lshlrev_b32 v220, 16, v220
  v_mov_b32 v200, v220
  v_mul_f32 v216, v216, v220
  v_sub_f32 v204, v204, v216
  v_add_f32 v221, v221, v1
  v_cvt_pk_bf16_f32 v221, v221, v221
  v_lshlrev_b32 v221, 16, v221
  v_sqrt_f32 v221, v221
  s_nop 0
  v_cvt_pk_bf16_f32 v221, v221, v221
  v_lshlrev_b32 v221, 16, v221
  v_rcp_f32 v221, v221
  s_nop 0
  v_cvt_pk_bf16_f32 v221, v221, v221
  v_lshlrev_b32 v221, 16, v221
  v_mul_f32 v221, v225, v221
  v_cvt_pk_bf16_f32 v221, v221, v221
  v_lshlrev_b32 v221, 16, v221
  v_mov_b32 v201, v221
  v_mul_f32 v217, v217, v221
  v_sub_f32 v205, v205, v217
  v_add_f32 v222, v222, v1
  v_cvt_pk_bf16_f32 v222, v222, v222
  v_lshlrev_b32 v222, 16, v222
  v_sqrt_f32 v222, v222
  s_nop 0
  v_cvt_pk_bf16_f32 v222, v222, v222
  v_lshlrev_b32 v222, 16, v222
  v_rcp_f32 v222, v222
  s_nop 0
  v_cvt_pk_bf16_f32 v222, v222, v222
  v_lshlrev_b32 v222, 16, v222
  v_mul_f32 v222, v226, v222
  v_cvt_pk_bf16_f32 v222, v222, v222
  v_lshlrev_b32 v222, 16, v222
  v_mov_b32 v202, v222
  v_mul_f32 v218, v218, v222
  v_sub_f32 v206, v206, v218
  v_add_f32 v223, v223, v1
  v_cvt_pk_bf16_f32 v223, v223, v223
  v_lshlrev_b32 v223, 16, v223
  v_sqrt_f32 v223, v223
  s_nop 0
  v_cvt_pk_bf16_f32 v223, v223, v223
  v_lshlrev_b32 v223, 16, v223
  v_rcp_f32 v223, v223
  s_nop 0
  v_cvt_pk_bf16_f32 v223, v223, v223
  v_lshlrev_b32 v223, 16, v223
  v_mul_f32 v223, v227, v223
  v_cvt_pk_bf16_f32 v223, v223, v223
  v_lshlrev_b32 v223, 16, v223
  v_mov_b32 v203, v223
  v_mul_f32 v219, v219, v223
  v_sub_f32 v207, v207, v219
  s_mov_b32 s52, 0
  s_mov_b32 s53, 0
  s_barrier
  ds_read_b64_tr_b16 v[104:105], v198 offset:0
  ds_read_b64_tr_b16 v[106:107], v198 offset:512
  ds_read_b64_tr_b16 v[108:109], v198 offset:8192
  ds_read_b64_tr_b16 v[110:111], v198 offset:8704
  ds_read_b64_tr_b16 v[112:113], v198 offset:16384
  ds_read_b64_tr_b16 v[114:115], v198 offset:16896
  ds_read_b128 v[48:51], v184 offset:0
  ds_read_b128 v[52:55], v185 offset:0
  ds_read_b128 v[56:59], v186 offset:0
  ds_read_b128 v[60:63], v187 offset:0
  ds_read_b128 v[64:67], v188 offset:0
  ds_read_b128 v[68:71], v189 offset:0
  ds_read_b128 v[72:75], v190 offset:0
  ds_read_b128 v[76:79], v184 offset:10240
  ds_read_b128 v[80:83], v185 offset:10240
  ds_read_b128 v[84:87], v186 offset:10240
  ds_read_b128 v[88:91], v187 offset:10240
  ds_read_b128 v[92:95], v188 offset:10240
  ds_read_b128 v[96:99], v189 offset:10240
  ds_read_b128 v[100:103], v190 offset:10240
L_cloop:
  s_mov_b32 s54, 20736
  s_mov_b32 s56, 24576
  s_cmp_eq_u32 s53, 2
  s_cselect_b32 s54, -41472, s54
  s_cselect_b32 s56, -49152, s56
  s_waitcnt lgkmcnt(0)
  v_mfma_f32_16x16x32_bf16 v[8:11], v[104:107], v[48:51], v[8:11]
  ds_read_b64_tr_b16 v[172:173], v199 offset:0
  v_mfma_f32_16x16x32_bf16 v[12:15], v[104:107], v[52:55], v[12:15]
  ds_read_b64_tr_b16 v[174:175], v199 offset:512
  v_mfma_f32_16x16x32_bf16 v[16:19], v[104:107], v[56:59], v[16:19]
  ds_read_b64_tr_b16 v[176:177], v199 offset:8192
  v_mfma_f32_16x16x32_bf16 v[20:23], v[104:107], v[60:63], v[20:23]
  ds_read_b64_tr_b16 v[178:179], v199 offset:8704
  v_mfma_f32_16x16x32_bf16 v[24:27], v[104:107], v[64:67], v[24:27]
  ds_read_b64_tr_b16 v[180:181], v199 offset:16384
  v_mfma_f32_16x16x32_bf16 v[28:31], v[104:107], v[76:79], v[28:31]
  ds_read_b64_tr_b16 v[182:183], v199 offset:16896
  v_mfma_f32_16x16x32_bf16 v[32:35], v[104:107], v[80:83], v[32:35]
  ds_read_b128 v[116:119], v191 offset:0
  v_mfma_f32_16x16x32_bf16 v[36:39], v[104:107], v[84:87], v[36:39]
  ds_read_b128 v[120:123], v192 offset:0
  v_mfma_f32_16x16x32_bf16 v[40:43], v[104:107], v[88:91], v[40:43]
  ds_read_b128 v[124:127], v193 offset:0
  v_mfma_f32_16x16x32_bf16 v[44:47], v[104:107], v[92:95], v[44:47]
  ds_read_b128 v[128:131], v194 offset:0
  v_mfma_f32_16x16x32_bf16 v[8:11], v[108:111], v[52:55], v[8:11]
  ds_read_b128 v[132:135], v195 offset:0
  v_mfma_f32_16x16x32_bf16 v[12:15], v[108:111], v[56:59], v[12:15]
  ds_read_b128 v[136:139], v196 offset:0
  v_mfma_f32_16x16x32_bf16 v[16:19], v[108:111], v[60:63], v[16:19]
  ds_read_b128 v[140:143], v197 offset:0
  v_mfma_f32_16x16x32_bf16 v[20:23], v[108:111], v[64:67], v[20:23]
  ds_read_b128 v[144:147], v191 offset:10240
  v_mfma_f32_16x16x32_bf16 v[24:27], v[108:111], v[68:71], v[24:27]
  ds_read_b128 v[148:151], v192 offset:10240
  v_mfma_f32_16x16x32_bf16 v[28:31], v[108:111], v[80:83], v[28:31]
  ds_read_b128 v[152:155], v193 offset:10240
  v_mfma_f32_16x16x32_bf16 v[32:35], v[108:111], v[84:87], v[32:35]
  ds_read_b128 v[156:159], v194 offset:10240
  v_mfma_f32_16x16x32_bf16 v[36:39], v[108:111], v[88:91], v[36:39]
  ds_read_b128 v[160:163], v195 offset:10240
  v_mfma_f32_16x16x32_bf16 v[40:43], v[108:111], v[92:95], v[40:43]
  ds_read_b128 v[164:167], v196 offset:10240
  v_mfma_f32_16x16x32_bf16 v[44:47], v[108:111], v[96:99], v[44:47]
  ds_read_b128 v[168:171], v197 offset:10240
  v_mfma_f32_16x16x32_bf16 v[8:11], v[112:115], v[56:59], v[8:11]
  v_add_u32 v184, s54, v184
  v_mfma_f32_16x16x32_bf16 v[12:15], v[112:115], v[60:63], v[12:15]
  v_add_u32 v185, s54, v185
  v_mfma_f32_16x16x32_bf16 v[16:19], v[112:115], v[64:67], v[16:19]
  v_add_u32 v186, s54, v186
  v_mfma_f32_16x16x32_bf16 v[20:23], v[112:115], v[68:71], v[20:23]
  v_add_u32 v187, s54, v187
  v_mfma_f32_16x16x32_bf16 v[24:27], v[112:115], v[72:75], v[24:27]
  v_add_u32 v188, s54, v188
  v_mfma_f32_16x16x32_bf16 v[28:31], v[112:115], v[84:87], v[28:31]
  v_add_u32 v189, s54, v189
  v_mfma_f32_16x16x32_bf16 v[32:35], v[112:115], v[88:91], v[32:35]
  v_add_u32 v190, s54, v190
  v_mfma_f32_16x16x32_bf16 v[36:39], v[112:115], v[92:95], v[36:39]
  v_add_u32 v198, s56, v198
  v_mfma_f32_16x16x32_bf16 v[40:43], v[112:115], v[96:99], v[40:43]
  v_mfma_f32_16x16x32_bf16 v[44:47], v[112:115], v[100:103], v[44:47]
  s_waitcnt lgkmcnt(0)
  s_barrier
  v_mfma_f32_16x16x32_bf16 v[8:11], v[172:175], v[116:119], v[8:11]
  ds_read_b64_tr_b16 v[104:105], v198 offset:0
  v_mfma_f32_16x16x32_bf16 v[12:15], v[172:175], v[120:123], v[12:15]
  ds_read_b64_tr_b16 v[106:107], v198 offset:512
  v_mfma_f32_16x16x32_bf16 v[16:19], v[172:175], v[124:127], v[16:19]
  ds_read_b64_tr_b16 v[108:109], v198 offset:8192
  v_mfma_f32_16x16x32_bf16 v[20:23], v[172:175], v[128:131], v[20:23]
  ds_read_b64_tr_b16 v[110:111], v198 offset:8704
  v_mfma_f32_16x16x32_bf16 v[24:27], v[172:175], v[132:135], v[24:27]
  ds_read_b64_tr_b16 v[112:113], v198 offset:16384
  v_mfma_f32_16x16x32_bf16 v[28:31], v[172:175], v[144:147], v[28:31]
  ds_read_b64_tr_b16 v[114:115], v198 offset:16896
  v_mfma_f32_16x16x32_bf16 v[32:35], v[172:175], v[148:151], v[32:35]
  ds_read_b128 v[48:51], v184 offset:0
  v_mfma_f32_16x16x32_bf16 v[36:39], v[172:175], v[152:155], v[36:39]
  ds_read_b128 v[52:55], v185 offset:0
  v_mfma_f32_16x16x32_bf16 v[40:43], v[172:175], v[156:159], v[40:43]
  ds_read_b128 v[56:59], v186 offset:0
  v_mfma_f32_16x16x32_bf16 v[44:47], v[172:175], v[160:163], v[44:47]
  ds_read_b128 v[60:63], v187 offset:0
  v_mfma_f32_16x16x32_bf16 v[8:11], v[176:179], v[120:123], v[8:11]
  ds_read_b128 v[64:67], v188 offset:0
  v_mfma_f32_16x16x32_bf16 v[12:15], v[176:179], v[124:127], v[12:15]
  ds_read_b128 v[68:71], v189 offset:0
  v_mfma_f32_16x16x32_bf16 v[16:19], v[176:179], v[128:131], v[16:19]
  ds_read_b128 v[72:75], v190 offset:0
  v_mfma_f32_16x16x32_bf16 v[20:23], v[176:179], v[132:135], v[20:23]
  ds_read_b128 v[76:79], v184 offset:10240
  v_mfma_f32_16x16x32_bf16 v[24:27], v[176:179], v[136:139], v[24:27]
  ds_read_b128 v[80:83], v185 offset:10240
  v_mfma_f32_16x16x32_bf16 v[28:31], v[176:179], v[148:151], v[28:31]
  ds_read_b128 v[84:87], v186 offset:10240
  v_mfma_f32_16x16x32_bf16 v[32:35], v[176:179], v[152:155], v[32:35]
  ds_read_b128 v[88:91], v187 offset:10240
  v_mfma_f32_16x16x32_bf16 v[36:39], v[176:179], v[156:159], v[36:39]
  ds_read_b128 v[92:95], v188 offset:10240
  v_mfma_f32_16x16x32_bf16 v[40:43], v[176:179], v[160:163], v[40:43]
  ds_read_b128 v[96:99], v189 offset:10240
  v_mfma_f32_16x16x32_bf16 v[44:47], v[176:179], v[164:167], v[44:47]
  ds_read_b128 v[100:103], v190 offset:10240
  v_mfma_f32_16x16x32_bf16 v[8:11], v[180:183], v[124:127], v[8:11]
  v_add_u32 v191, s54, v191
  v_mfma_f32_16x16x32_bf16 v[12:15], v[180:183], v[128:131], v[12:15]
  v_add_u32 v192, s54, v192
  v_mfma_f32_16x16x32_bf16 v[16:19], v[180:183], v[132:135], v[16:19]
  v_add_u32 v193, s54, v193
  v_mfma_f32_16x16x32_bf16 v[20:23], v[180:183], v[136:139], v[20:23]
  v_add_u32 v194, s54, v194
  v_mfma_f32_16x16x32_bf16 v[24:27], v[180:183], v[140:143], v[24:27]
  v_add_u32 v195, s54, v195
  v_mfma_f32_16x16x32_bf16 v[28:31], v[180:183], v[152:155], v[28:31]
  v_add_u32 v196, s54, v196
  v_mfma_f32_16x16x32_bf16 v[32:35], v[180:183], v[156:159], v[32:35]
  v_add_u32 v197, s54, v197
  v_mfma_f32_16x16x32_bf16 v[36:39], v[180:183], v[160:163], v[36:39]
  v_add_u32 v199, s56, v199
  v_mfma_f32_16x16x32_bf16 v[40:43], v[180:183], v[164:167], v[40:43]
  s_add_u32 s53, s53, 1
  v_mfma_f32_16x16x32_bf16 v[44:47], v[180:183], v[168:171], v[44:47]
  s_cmp_eq_u32 s53, 3
  s_cselect_b32 s53, 0, s53
  s_add_u32 s52, s52, 1
  s_cmp_lt_u32 s52, 8
  s_cbranch_scc1 L_cloop
  s_waitcnt lgkmcnt(0)
  v_mfma_f32_16x16x32_bf16 v[8:11], v[104:107], v[48:51], v[8:11]
  ds_read_b64_tr_b16 v[172:173], v199 offset:0
  v_mfma_f32_16x16x32_bf16 v[12:15], v[104:107], v[52:55], v[12:15]
  ds_read_b64_tr_b16 v[174:175], v199 offset:512
  v_mfma_f32_16x16x32_bf16 v[16:19], v[104:107], v[56:59], v[16:19]
  ds_read_b64_tr_b16 v[176:177], v199 offset:8192
  v_mfma_f32_16x16x32_bf16 v[20:23], v[104:107], v[60:63], v[20:23]
  ds_read_b64_tr_b16 v[178:179], v199 offset:8704
  v_mfma_f32_16x16x32_bf16 v[24:27], v[104:107], v[64:67], v[24:27]
  ds_read_b64_tr_b16 v[180:181], v199 offset:16384
  v_mfma_f32_16x16x32_bf16 v[28:31], v[104:107], v[76:79], v[28:31]
  ds_read_b64_tr_b16 v[182:183], v199 offset:16896
  v_mfma_f32_16x16x32_bf16 v[32:35], v[104:107], v[80:83], v[32:35]
  ds_read_b128 v[116:119], v191 offset:0
  v_mfma_f32_16x16x32_bf16 v[36:39], v[104:107], v[84:87], v[36:39]
  ds_read_b128 v[120:123], v192 offset:0
  v_mfma_f32_16x16x32_bf16 v[40:43], v[104:107], v[88:91], v[40:43]
  ds_read_b128 v[124:127], v193 offset:0
  v_mfma_f32_16x16x32_bf16 v[44:47], v[104:107], v[92:95], v[44:47]
  ds_read_b128 v[128:131], v194 offset:0
  v_mfma_f32_16x16x32_bf16 v[8:11], v[108:111], v[52:55], v[8:11]
  ds_read_b128 v[132:135], v195 offset:0
  v_mfma_f32_16x16x32_bf16 v[12:15], v[108:111], v[56:59], v[12:15]
  ds_read_b128 v[136:139], v196 offset:0
  v_mfma_f32_16x16x32_bf16 v[16:19], v[108:111], v[60:63], v[16:19]
  ds_read_b128 v[140:143], v197 offset:0
  v_mfma_f32_16x16x32_bf16 v[20:23], v[108:111], v[64:67], v[20:23]
  ds_read_b128 v[144:147], v191 offset:10240
  v_mfma_f32_16x16x32_bf16 v[24:27], v[108:111], v[68:71], v[24:27]
  ds_read_b128 v[148:151], v192 offset:10240
  v_mfma_f32_16x16x32_bf16 v[28:31], v[108:111], v[80:83], v[28:31]
  ds_read_b128 v[152:155], v193 offset:10240
  v_mfma_f32_16x16x32_bf16 v[32:35], v[108:111], v[84:87], v[32:35]
  ds_read_b128 v[156:159], v194 offset:10240
  v_mfma_f32_16x16x32_bf16 v[36:39], v[108:111], v[88:91], v[36:39]
  ds_read_b128 v[160:163], v195 offset:10240
  v_mfma_f32_16x16x32_bf16 v[40:43], v[108:111], v[92:95], v[40:43]
  ds_read_b128 v[164:167], v196 offset:10240
  v_mfma_f32_16x16x32_bf16 v[44:47], v[108:111], v[96:99], v[44:47]
  ds_read_b128 v[168:171], v197 offset:10240
  v_mfma_f32_16x16x32_bf16 v[8:11], v[112:115], v[56:59], v[8:11]
  v_mfma_f32_16x16x32_bf16 v[12:15], v[112:115], v[60:63], v[12:15]
  v_mfma_f32_16x16x32_bf16 v[16:19], v[112:115], v[64:67], v[16:19]
  v_mfma_f32_16x16x32_bf16 v[20:23], v[112:115], v[68:71], v[20:23]
  v_mfma_f32_16x16x32_bf16 v[24:27], v[112:115], v[72:75], v[24:27]
  v_mfma_f32_16x16x32_bf16 v[28:31], v[112:115], v[84:87], v[28:31]
  v_mfma_f32_16x16x32_bf16 v[32:35], v[112:115], v[88:91], v[32:35]
  v_mfma_f32_16x16x32_bf16 v[36:39], v[112:115], v[92:95], v[36:39]
  v_mfma_f32_16x16x32_bf16 v[40:43], v[112:115], v[96:99], v[40:43]
  v_mfma_f32_16x16x32_bf16 v[44:47], v[112:115], v[100:103], v[44:47]
  s_waitcnt lgkmcnt(0)
  v_mov_b32 v1, 0xbfb8aa3b
  v_mfma_f32_16x16x32_bf16 v[8:11], v[172:175], v[116:119], v[8:11]
  v_mfma_f32_16x16x32_bf16 v[12:15], v[172:175], v[120:123], v[12:15]
  v_mfma_f32_16x16x32_bf16 v[8:11], v[176:179], v[120:123], v[8:11]
  v_mfma_f32_16x16x32_bf16 v[12:15], v[176:179], v[124:127], v[12:15]
  v_mfma_f32_16x16x32_bf16 v[8:11], v[180:183], v[124:127], v[8:11]
  v_mfma_f32_16x16x32_bf16 v[12:15], v[180:183], v[128:131], v[12:15]
  v_mfma_f32_16x16x32_bf16 v[16:19], v[172:175], v[124:127], v[16:19]
  v_mfma_f32_16x16x32_bf16 v[20:23], v[172:175], v[128:131], v[20:23]
  v_mfma_f32_16x16x32_bf16 v[16:19], v[176:179], v[128:131], v[16:19]
  v_mfma_f32_16x16x32_bf16 v[20:23], v[176:179], v[132:135], v[20:23]
  v_mfma_f32_16x16x32_bf16 v[16:19], v[180:183], v[132:135], v[16:19]
  v_mfma_f32_16x16x32_bf16 v[20:23], v[180:183], v[136:139], v[20:23]
  v_fma_f32 v8, v8, v200, v204
  v_fma_f32 v9, v9, v201, v205
  v_fma_f32 v10, v10, v202, v206
  v_fma_f32 v11, v11, v203, v207
  v_mul_f32 v208, v8, v1
  v_mul_f32 v209, v9, v1
  v_mul_f32 v210, v10, v1
  v_mul_f32 v211, v11, v1
  v_exp_f32 v208, v208
  v_exp_f32 v209, v209
  v_exp_f32 v210, v210
  v_exp_f32 v211, v211
  v_add_f32 v208, 1.0, v208
  v_add_f32 v209, 1.0, v209
  v_add_f32 v210, 1.0, v210
  v_add_f32 v211, 1.0, v211
  v_rcp_f32 v208, v208
  v_rcp_f32 v209, v209
  v_rcp_f32 v210, v210
  v_rcp_f32 v211, v211
  v_mul_f32 v208, v8, v208
  v_mul_f32 v209, v9, v209
  v_mul_f32 v210, v10, v210
  v_mul_f32 v211, v11, v211
  v_cvt_pk_bf16_f32 v212, v208, v209
  v_cvt_pk_bf16_f32 v213, v210, v211
  ds_write_b64 v232, v[212:213] offset:20736
  v_fma_f32 v12, v12, v200, v204
  v_fma_f32 v13, v13, v201, v205
  v_fma_f32 v14, v14, v202, v206
  v_fma_f32 v15, v15, v203, v207
  v_mul_f32 v218, v12, v1
  v_mul_f32 v219, v13, v1
  v_mul_f32 v220, v14, v1
  v_mul_f32 v221, v15, v1
  v_exp_f32 v218, v218
  v_exp_f32 v219, v219
  v_exp_f32 v220, v220
  v_exp_f32 v221, v221
  v_add_f32 v218, 1.0, v218
  v_add_f32 v219, 1.0, v219
  v_add_f32 v220, 1.0, v220
  v_add_f32 v221, 1.0, v221
  v_rcp_f32 v218, v218
  v_rcp_f32 v219, v219
  v_rcp_f32 v220, v220
  v_rcp_f32 v221, v221
  v_mul_f32 v218, v12, v218
  v_mul_f32 v219, v13, v219
  v_mul_f32 v220, v14, v220
  v_mul_f32 v221, v15, v221
  v_cvt_pk_bf16_f32 v222, v218, v219
  v_cvt_pk_bf16_f32 v223, v220, v221
  ds_write_b64 v233, v[222:223] offset:20736
  v_mfma_f32_16x16x32_bf16 v[24:27], v[172:175], v[132:135], v[24:27]
  v_mfma_f32_16x16x32_bf16 v[28:31], v[172:175], v[144:147], v[28:31]
  v_mfma_f32_16x16x32_bf16 v[24:27], v[176:179], v[136:139], v[24:27]
  v_mfma_f32_16x16x32_bf16 v[28:31], v[176:179], v[148:151], v[28:31]
  v_mfma_f32_16x16x32_bf16 v[24:27], v[180:183], v[140:143], v[24:27]
  v_mfma_f32_16x16x32_bf16 v[28:31], v[180:183], v[152:155], v[28:31]
  v_fma_f32 v16, v16, v200, v204
  v_fma_f32 v17, v17, v201, v205
  v_fma_f32 v18, v18, v202, v206
  v_fma_f32 v19, v19, v203, v207
  v_mul_f32 v208, v16, v1
  v_mul_f32 v209, v17, v1
  v_mul_f32 v210, v18, v1
  v_mul_f32 v211, v19, v1
  v_exp_f32 v208, v208
  v_exp_f32 v209, v209
  v_exp_f32 v210, v210
  v_exp_f32 v211, v211
  v_add_f32 v208, 1.0, v208
  v_add_f32 v209, 1.0, v209
  v_add_f32 v210, 1.0, v210
  v_add_f32 v211, 1.0, v211
  v_rcp_f32 v208, v208
  v_rcp_f32 v209, v209
  v_rcp_f32 v210, v210
  v_rcp_f32 v211, v211
  v_mul_f32 v208, v16, v208
  v_mul_f32 v209, v17, v209
  v_mul_f32 v210, v18, v210
  v_mul_f32 v211, v19, v211
  v_cvt_pk_bf16_f32 v212, v208, v209
  v_cvt_pk_bf16_f32 v213, v210, v211
  ds_write_b64 v234, v[212:213] offset:20736
  v_fma_f32 v20, v20, v200, v204
  v_fma_f32 v21, v21, v201, v205
  v_fma_f32 v22, v22, v202, v206
  v_fma_f32 v23, v23, v203, v207
  v_mul_f32 v218, v20, v1
  v_mul_f32 v219, v21, v1
  v_mul_f32 v220, v22, v1
  v_mul_f32 v221, v23, v1
  v_exp_f32 v218, v218
  v_exp_f32 v219, v219
  v_exp_f32 v220, v220
  v_exp_f32 v221, v221
  v_add_f32 v218, 1.0, v218
  v_add_f32 v219, 1.0, v219
  v_add_f32 v220, 1.0, v220
  v_add_f32 v221, 1.0, v221
  v_rcp_f32 v218, v218
  v_rcp_f32 v219, v219
  v_rcp_f32 v220, v220
  v_rcp_f32 v221, v221
  v_mul_f32 v218, v20, v218
  v_mul_f32 v219, v21, v219
  v_mul_f32 v220, v22, v220
  v_mul_f32 v221, v23, v221
  v_cvt_pk_bf16_f32 v222, v218, v219
  v_cvt_pk_bf16_f32 v223, v220, v221
  ds_write_b64 v235, v[222:223] offset:20736
  v_mfma_f32_16x16x32_bf16 v[32:35], v[172:175], v[148:151], v[32:35]
  v_mfma_f32_16x16x32_bf16 v[36:39], v[172:175], v[152:155], v[36:39]
  v_mfma_f32_16x16x32_bf16 v[32:35], v[176:179], v[152:155], v[32:35]
  v_mfma_f32_16x16x32_bf16 v[36:39], v[176:179], v[156:159], v[36:39]
  v_mfma_f32_16x16x32_bf16 v[32:35], v[180:183], v[156:159], v[32:35]
  v_mfma_f32_16x16x32_bf16 v[36:39], v[180:183], v[160:163], v[36:39]
  v_fma_f32 v24, v24, v200, v204
  v_fma_f32 v25, v25, v201, v205
  v_fma_f32 v26, v26, v202, v206
  v_fma_f32 v27, v27, v203, v207
  v_mul_f32 v208, v24, v1
  v_mul_f32 v209, v25, v1
  v_mul_f32 v210, v26, v1
  v_mul_f32 v211, v27, v1
  v_exp_f32 v208, v208
  v_exp_f32 v209, v209
  v_exp_f32 v210, v210
  v_exp_f32 v211, v211
  v_add_f32 v208, 1.0, v208
  v_add_f32 v209, 1.0, v209
  v_add_f32 v210, 1.0, v210
  v_add_f32 v211, 1.0, v211
  v_rcp_f32 v208, v208
  v_rcp_f32 v209, v209
  v_rcp_f32 v210, v210
  v_rcp_f32 v211, v211
  v_mul_f32 v208, v24, v208
  v_mul_f32 v209, v25, v209
  v_mul_f32 v210, v26, v210
  v_mul_f32 v211, v27, v211
  v_cvt_pk_bf16_f32 v212, v208, v209
  v_cvt_pk_bf16_f32 v213, v210, v211
  ds_write_b64 v236, v[212:213] offset:20736
  v_fma_f32 v28, v28, v200, v204
  v_fma_f32 v29, v29, v201, v205
  v_fma_f32 v30, v30, v202, v206
  v_fma_f32 v31, v31, v203, v207
  v_mul_f32 v218, v28, v1
  v_mul_f32 v219, v29, v1
  v_mul_f32 v220, v30, v1
  v_mul_f32 v221, v31, v1
  v_exp_f32 v218, v218
  v_exp_f32 v219, v219
  v_exp_f32 v220, v220
  v_exp_f32 v221, v221
  v_add_f32 v218, 1.0, v218
  v_add_f32 v219, 1.0, v219
  v_add_f32 v220, 1.0, v220
  v_add_f32 v221, 1.0, v221
  v_rcp_f32 v218, v218
  v_rcp_f32 v219, v219
  v_rcp_f32 v220, v220
  v_rcp_f32 v221, v221
  v_mul_f32 v218, v28, v218
  v_mul_f32 v219, v29, v219
  v_mul_f32 v220, v30, v220
  v_mul_f32 v221, v31, v221
  v_cvt_pk_bf16_f32 v222, v218, v219
  v_cvt_pk_bf16_f32 v223, v220, v221
  ds_write_b64 v232, v[222:223] offset:30976
  v_mfma_f32_16x16x32_bf16 v[40:43], v[172:175], v[156:159], v[40:43]
  v_mfma_f32_16x16x32_bf16 v[44:47], v[172:175], v[160:163], v[44:47]
  v_mfma_f32_16x16x32_bf16 v[40:43], v[176:179], v[160:163], v[40:43]
  v_mfma_f32_16x16x32_bf16 v[44:47], v[176:179], v[164:167], v[44:47]
  v_mfma_f32_16x16x32_bf16 v[40:43], v[180:183], v[164:167], v[40:43]
  v_mfma_f32_16x16x32_bf16 v[44:47], v[180:183], v[168:171], v[44:47]
  v_fma_f32 v32, v32, v200, v204
  v_fma_f32 v33, v33, v201, v205
  v_fma_f32 v34, v34, v202, v206
  v_fma_f32 v35, v35, v203, v207
  v_mul_f32 v208, v32, v1
  v_mul_f32 v209, v33, v1
  v_mul_f32 v210, v34, v1
  v_mul_f32 v211, v35, v1
  v_exp_f32 v208, v208
  v_exp_f32 v209, v209
  v_exp_f32 v210, v210
  v_exp_f32 v211, v211
  v_add_f32 v208, 1.0, v208
  v_add_f32 v209, 1.0, v209
  v_add_f32 v210, 1.0, v210
  v_add_f32 v211, 1.0, v211
  v_rcp_f32 v208, v208
  v_rcp_f32 v209, v209
  v_rcp_f32 v210, v210
  v_rcp_f32 v211, v211
  v_mul_f32 v208, v32, v208
  v_mul_f32 v209, v33, v209
  v_mul_f32 v210, v34, v210
  v_mul_f32 v211, v35, v211
  v_cvt_pk_bf16_f32 v212, v208, v209
  v_cvt_pk_bf16_f32 v213, v210, v211
  ds_write_b64 v233, v[212:213] offset:30976
  v_fma_f32 v36, v36, v200, v204
  v_fma_f32 v37, v37, v201, v205
  v_fma_f32 v38, v38, v202, v206
  v_fma_f32 v39, v39, v203, v207
  v_mul_f32 v218, v36, v1
  v_mul_f32 v219, v37, v1
  v_mul_f32 v220, v38, v1
  v_mul_f32 v221, v39, v1
  v_exp_f32 v218, v218
  v_exp_f32 v219, v219
  v_exp_f32 v220, v220
  v_exp_f32 v221, v221
  v_add_f32 v218, 1.0, v218
  v_add_f32 v219, 1.0, v219
  v_add_f32 v220, 1.0, v220
  v_add_f32 v221, 1.0, v221
  v_rcp_f32 v218, v218
  v_rcp_f32 v219, v219
  v_rcp_f32 v220, v220
  v_rcp_f32 v221, v221
  v_mul_f32 v218, v36, v218
  v_mul_f32 v219, v37, v219
  v_mul_f32 v220, v38, v220
  v_mul_f32 v221, v39, v221
  v_cvt_pk_bf16_f32 v222, v218, v219
  v_cvt_pk_bf16_f32 v223, v220, v221
  ds_write_b64 v234, v[222:223] offset:30976
  s_nop 7
  v_fma_f32 v40, v40, v200, v204
  v_fma_f32 v41, v41, v201, v205
  v_fma_f32 v42, v42, v202, v206
  v_fma_f32 v43, v43, v203, v207
  v_mul_f32 v208, v40, v1
  v_mul_f32 v209, v41, v1
  v_mul_f32 v210, v42, v1
  v_mul_f32 v211, v43, v1
  v_exp_f32 v208, v208
  v_exp_f32 v209, v209
  v_exp_f32 v210, v210
  v_exp_f32 v211, v211
  v_add_f32 v208, 1.0, v208
  v_add_f32 v209, 1.0, v209
  v_add_f32 v210, 1.0, v210
  v_add_f32 v211, 1.0, v211
  v_rcp_f32 v208, v208
  v_rcp_f32 v209, v209
  v_rcp_f32 v210, v210
  v_rcp_f32 v211, v211
  v_mul_f32 v208, v40, v208
  v_mul_f32 v209, v41, v209
  v_mul_f32 v210, v42, v210
  v_mul_f32 v211, v43, v211
  v_cvt_pk_bf16_f32 v212, v208, v209
  v_cvt_pk_bf16_f32 v213, v210, v211
  ds_write_b64 v235, v[212:213] offset:30976
  v_fma_f32 v44, v44, v200, v204
  v_fma_f32 v45, v45, v201, v205
  v_fma_f32 v46, v46, v202, v206
  v_fma_f32 v47, v47, v203, v207
  v_mul_f32 v218, v44, v1
  v_mul_f32 v219, v45, v1
  v_mul_f32 v220, v46, v1
  v_mul_f32 v221, v47, v1
  v_exp_f32 v218, v218
  v_exp_f32 v219, v219
  v_exp_f32 v220, v220
  v_exp_f32 v221, v221
  v_add_f32 v218, 1.0, v218
  v_add_f32 v219, 1.0, v219
  v_add_f32 v220, 1.0, v220
  v_add_f32 v221, 1.0, v221
  v_rcp_f32 v218, v218
  v_rcp_f32 v219, v219
  v_rcp_f32 v220, v220
  v_rcp_f32 v221, v221
  v_mul_f32 v218, v44, v218
  v_mul_f32 v219, v45, v219
  v_mul_f32 v220, v46, v220
  v_mul_f32 v221, v47, v221
  v_cvt_pk_bf16_f32 v222, v218, v219
  v_cvt_pk_bf16_f32 v223, v220, v221
  ds_write_b64 v236, v[222:223] offset:30976
  s_waitcnt lgkmcnt(0)
  s_barrier
  ds_read_b128 v[48:51], v237 offset:20736
  ds_read_b128 v[52:55], v237 offset:24832
  ds_read_b128 v[56:59], v237 offset:28928
  ds_read_b128 v[60:63], v237 offset:33024
  ds_read_b128 v[64:67], v237 offset:37120
  s_waitcnt lgkmcnt(4)
  s_mov_b32 s30, 0
  buffer_store_dwordx4 v[48:51], v238, s[32:35], s30 offen
  s_waitcnt lgkmcnt(3)
  s_mov_b32 s30, 36864
  buffer_store_dwordx4 v[52:55], v238, s[32:35], s30 offen
  s_waitcnt lgkmcnt(2)
  s_mov_b32 s30, 73728
  buffer_store_dwordx4 v[56:59], v238, s[32:35], s30 offen
  s_waitcnt lgkmcnt(1)
  s_mov_b32 s30, 110592
  buffer_store_dwordx4 v[60:63], v238, s[32:35], s30 offen
  s_waitcnt lgkmcnt(0)
  s_mov_b32 s30, 147456
  buffer_store_dwordx4 v[64:67], v238, s[32:35], s30 offen
  s_branch L_end
L_loader:
  s_mul_i32 s30, s25, 2359296
  s_add_u32 s32, s4, s30
  s_addc_u32 s33, s5, 0
  s_mov_b32 s34, 2359296
  s_mov_b32 s35, 0x00020000
  s_lshl_b32 s30, s24, 7
  s_add_u32 s36, s6, s30
  s_addc_u32 s37, s7, 0
  s_sub_u32 s38, 1990656, s30
  s_mov_b32 s39, 0x00020000
  s_mul_i32 s40, s27, 1152
  s_sub_u32 s40, s40, 1152
  s_cmp_eq_u32 s26, 0
  s_cselect_b32 s41, 0, s40
  s_cselect_b32 s42, -1, 0
  v_lshrrev_b32 v1, 3, v0
  v_and_b32 v2, 7, v0
  v_mul_u32_u24 v3, 1152, v1
  v_xor_b32 v4, v2, v1
  v_lshlrev_b32 v4, 4, v4
  v_add_u32 v4, v3, v4
  v_subrev_u32 v5, 1152, v4
  v_mov_b32 v6, 0x40000000
  v_cmp_gt_u32 vcc, 8, v0
  v_cndmask_b32 v5, v5, v6, vcc
  v_mov_b32 v6, s42
  v_cmp_ne_u32 vcc, 0, v6
  v_cndmask_b32 v5, v4, v5, vcc
  v_lshrrev_b32 v6, 1, v1
  v_and_b32 v6, 1, v6
  v_lshrrev_b32 v7, 1, v2
  v_xor_b32 v8, v7, v6
  v_xor_b32 v9, 2, v8
  v_and_b32 v10, 1, v2
  v_lshlrev_b32 v8, 5, v8
  v_lshlrev_b32 v9, 5, v9
  v_lshlrev_b32 v10, 4, v10
  v_add_u32 v8, v8, v10
  v_add_u32 v9, v9, v10
  v_add_u32 v6, v3, v8
  v_add_u32 v7, v3, v9
  s_cmp_lg_u32 s29, 4
  s_cbranch_scc1 L_loader1
  s_mov_b32 s45, 0
  s_mov_b32 s46, 0
  s_mov_b32 s47, 0
  s_mov_b32 s50, 0
L_lloop0:
  s_mul_i32 s48, s50, 20736
  s_mul_i32 s49, s50, 24576
  s_add_u32 s49, s49, 62208
  s_add_u32 s51, s40, s46
  s_add_u32 m0, s48, 0
  s_add_u32 s44, s41, s46
  buffer_load_dwordx4 v5, s[32:35], s44 offen nt lds
  s_add_u32 m0, s48, 2048
  s_add_u32 s44, s51, 18432
  buffer_load_dwordx4 v4, s[32:35], s44 offen nt lds
  s_add_u32 m0, s48, 4096
  s_add_u32 s44, s51, 36864
  buffer_load_dwordx4 v4, s[32:35], s44 offen nt lds
  s_add_u32 m0, s48, 6144
  s_add_u32 s44, s51, 55296
  buffer_load_dwordx4 v4, s[32:35], s44 offen nt lds
  s_add_u32 m0, s48, 8192
  s_add_u32 s44, s51, 73728
  buffer_load_dwordx4 v4, s[32:35], s44 offen nt lds
  s_add_u32 m0, s48, 10240
  s_add_u32 s44, s51, 92160
  buffer_load_dwordx4 v4, s[32:35], s44 offen nt lds
  s_add_u32 m0, s48, 12288
  s_add_u32 s44, s51, 110592
  buffer_load_dwordx4 v4, s[32:35], s44 offen nt lds
  s_add_u32 m0, s48, 14336
  s_add_u32 s44, s51, 129024
  buffer_load_dwordx4 v4, s[32:35], s44 offen nt lds
  s_add_u32 m0, s48, 16384
  s_add_u32 s44, s51, 147456
  buffer_load_dwordx4 v4, s[32:35], s44 offen nt lds
  s_add_u32 m0, s48, 18432
  s_add_u32 s44, s51, 165888
  buffer_load_dwordx4 v4, s[32:35], s44 offen nt lds
  s_add_u32 m0, s49, 1024
  s_add_u32 s44, s47, 9216
  buffer_load_dwordx4 v7, s[36:39], s44 offen  lds
  s_add_u32 m0, s49, 3072
  s_add_u32 s44, s47, 27648
  buffer_load_dwordx4 v7, s[36:39], s44 offen  lds
  s_add_u32 m0, s49, 5120
  s_add_u32 s44, s47, 46080
  buffer_load_dwordx4 v7, s[36:39], s44 offen  lds
  s_add_u32 m0, s49, 7168
  s_add_u32 s44, s47, 64512
  buffer_load_dwordx4 v7, s[36:39], s44 offen  lds
  s_add_u32 m0, s49, 9216
  s_add_u32 s44, s47, 672768
  buffer_load_dwordx4 v7, s[36:39], s44 offen  lds
  s_add_u32 m0, s49, 11264
  s_add_u32 s44, s47, 691200
  buffer_load_dwordx4 v7, s[36:39], s44 offen  lds
  s_add_u32 m0, s49, 13312
  s_add_u32 s44, s47, 709632
  buffer_load_dwordx4 v7, s[36:39], s44 offen  lds
  s_add_u32 m0, s49, 15360
  s_add_u32 s44, s47, 728064
  buffer_load_dwordx4 v7, s[36:39], s44 offen  lds
  s_add_u32 m0, s49, 17408
  s_add_u32 s44, s47, 1336320
  buffer_load_dwordx4 v7, s[36:39], s44 offen  lds
  s_add_u32 m0, s49, 19456
  s_add_u32 s44, s47, 1354752
  buffer_load_dwordx4 v7, s[36:39], s44 offen  lds
  s_add_u32 m0, s49, 21504
  s_add_u32 s44, s47, 1373184
  buffer_load_dwordx4 v7, s[36:39], s44 offen  lds
  s_add_u32 m0, s49, 23552
  s_add_u32 s44, s47, 1391616
  buffer_load_dwordx4 v7, s[36:39], s44 offen  lds
  s_cmp_eq_u32 s45, 0
  s_cbranch_scc1 L_lnext0
  s_waitcnt vmcnt(22)
  s_barrier
L_lnext0:
  s_add_u32 s45, s45, 1
  s_add_u32 s46, s46, 128
  s_add_u32 s47, s47, 73728
  s_add_u32 s50, s50, 1
  s_cmp_eq_u32 s50, 3
  s_cselect_b32 s50, 0, s50
  s_cmp_lt_u32 s45, 9
  s_cbranch_scc1 L_lloop0
  s_waitcnt vmcnt(0)
  s_barrier
  s_barrier
  s_branch L_end
L_loader1:
  s_mov_b32 s45, 0
  s_mov_b32 s46, 0
  s_mov_b32 s47, 0
  s_mov_b32 s50, 0
L_lloop1:
  s_mul_i32 s48, s50, 20736
  s_mul_i32 s49, s50, 24576
  s_add_u32 s49, s49, 62208
  s_add_u32 s51, s40, s46
  s_add_u32 m0, s48, 1024
  s_add_u32 s44, s51, 9216
  buffer_load_dwordx4 v4, s[32:35], s44 offen nt lds
  s_add_u32 m0, s48, 3072
  s_add_u32 s44, s51, 27648
  buffer_load_dwordx4 v4, s[32:35], s44 offen nt lds
  s_add_u32 m0, s48, 5120
  s_add_u32 s44, s51, 46080
  buffer_load_dwordx4 v4, s[32:35], s44 offen nt lds
  s_add_u32 m0, s48, 7168
  s_add_u32 s44, s51, 64512
  buffer_load_dwordx4 v4, s[32:35], s44 offen nt lds
  s_add_u32 m0, s48, 9216
  s_add_u32 s44, s51, 82944
  buffer_load_dwordx4 v4, s[32:35], s44 offen nt lds
  s_add_u32 m0, s48, 11264
  s_add_u32 s44, s51, 101376
  buffer_load_dwordx4 v4, s[32:35], s44 offen nt lds
  s_add_u32 m0, s48, 13312
  s_add_u32 s44, s51, 119808
  buffer_load_dwordx4 v4, s[32:35], s44 offen nt lds
  s_add_u32 m0, s48, 15360
  s_add_u32 s44, s51, 138240
  buffer_load_dwordx4 v4, s[32:35], s44 offen nt lds
  s_add_u32 m0, s48, 17408
  s_add_u32 s44, s51, 156672
  buffer_load_dwordx4 v4, s[32:35], s44 offen nt lds
  s_add_u32 m0, s49, 0
  s_add_u32 s44, s47, 0
  buffer_load_dwordx4 v6, s[36:39], s44 offen  lds
  s_add_u32 m0, s49, 2048
  s_add_u32 s44, s47, 18432
  buffer_load_dwordx4 v6, s[36:39], s44 offen  lds
  s_add_u32 m0, s49, 4096
  s_add_u32 s44, s47, 36864
  buffer_load_dwordx4 v6, s[36:39], s44 offen  lds
  s_add_u32 m0, s49, 6144
  s_add_u32 s44, s47, 55296
  buffer_load_dwordx4 v6, s[36:39], s44 offen  lds
  s_add_u32 m0, s49, 8192
  s_add_u32 s44, s47, 663552
  buffer_load_dwordx4 v6, s[36:39], s44 offen  lds
  s_add_u32 m0, s49, 10240
  s_add_u32 s44, s47, 681984
  buffer_load_dwordx4 v6, s[36:39], s44 offen  lds
  s_add_u32 m0, s49, 12288
  s_add_u32 s44, s47, 700416
  buffer_load_dwordx4 v6, s[36:39], s44 offen  lds
  s_add_u32 m0, s49, 14336
  s_add_u32 s44, s47, 718848
  buffer_load_dwordx4 v6, s[36:39], s44 offen  lds
  s_add_u32 m0, s49, 16384
  s_add_u32 s44, s47, 1327104
  buffer_load_dwordx4 v6, s[36:39], s44 offen  lds
  s_add_u32 m0, s49, 18432
  s_add_u32 s44, s47, 1345536
  buffer_load_dwordx4 v6, s[36:39], s44 offen  lds
  s_add_u32 m0, s49, 20480
  s_add_u32 s44, s47, 1363968
  buffer_load_dwordx4 v6, s[36:39], s44 offen  lds
  s_add_u32 m0, s49, 22528
  s_add_u32 s44, s47, 1382400
  buffer_load_dwordx4 v6, s[36:39], s44 offen  lds
  s_cmp_eq_u32 s45, 0
  s_cbranch_scc1 L_lnext1
  s_waitcnt vmcnt(21)
  s_barrier
L_lnext1:
  s_add_u32 s45, s45, 1
  s_add_u32 s46, s46, 128
  s_add_u32 s47, s47, 73728
  s_add_u32 s50, s50, 1
  s_cmp_eq_u32 s50, 3
  s_cselect_b32 s50, 0, s50
  s_cmp_lt_u32 s45, 9
  s_cbranch_scc1 L_lloop1
  s_waitcnt vmcnt(0)
  s_barrier
  s_barrier
  s_branch L_end
L_end:
s_endpgm
.section .rodata,"a"
.p2align 6
.amdhsa_kernel standalone__batchnorm__prompt_kernel
  .amdhsa_next_free_vgpr 240
  .amdhsa_next_free_sgpr 102
  .amdhsa_accum_offset 240
  .amdhsa_group_segment_fixed_size 0
  .amdhsa_kernarg_size 72
  .amdhsa_user_sgpr_count 2
  .amdhsa_user_sgpr_kernarg_segment_ptr 1
  .amdhsa_system_sgpr_workgroup_id_x 1
.end_amdhsa_kernel
```
